```python
import torch

def _softmax(x, axis=-1):
    return torch.softmax(x, dim=axis)
def _gelu(x):
    return torch.nn.functional.gelu(x, approximate="tanh")
def _silu(x):
    return torch.nn.functional.silu(x)
def _sigmoid(x):
    return torch.sigmoid(x)
def _layernorm(x, axis=-1, eps=1e-5):
    m = x.mean(dim=axis, keepdim=True)
    v = x.var(dim=axis, keepdim=True, unbiased=False)
    return (x - m) / torch.sqrt(v + eps)
def _scatter_add(tgt, idx, src, axis=0):
    return tgt.clone().index_add_(axis, idx, src)
def _segment_sum(src, seg, n):
    out = torch.zeros((n,) + src.shape[1:], dtype=src.dtype)
    return out.index_add_(0, seg, src)
def _pad(x, pw):
    flat = tuple(v for pair in reversed(pw) for v in pair)
    return torch.nn.functional.pad(x, flat)

kernel_name = 'gather_scatter__edge_featured_mpnn_gatedgcn__graph'

def setup_inputs():

    _w = (lambda a: (lambda t: t.to(torch.bfloat16) if t.is_floating_point() else t)(torch.as_tensor(a)))
    N, deg, D, De = 10000, 32, 128, max(0, 1)
    E = N * deg
    return {
        "x": _w((lambda *s: torch.randn(*s, dtype=torch.bfloat16) * 0.4)(N, D)),
        "e_attr": _w((lambda *s: torch.randn(*s, dtype=torch.bfloat16) * 1.6)(E, De)),
        "src": _w((lambda lo, hi, *s: torch.randint(lo, hi, s))(0, N, E).to(torch.int64)),
        "dst": _w((lambda lo, hi, *s: torch.randint(lo, hi, s))(0, N, E).to(torch.int64)),
        "w_a": _w((lambda *s: torch.randn(*s, dtype=torch.bfloat16) * 0.4)(D, D)),
        "w_b": _w((lambda *s: torch.randn(*s, dtype=torch.bfloat16) * 0.4)(D, D)),
        "w_c": _w((lambda *s: torch.randn(*s, dtype=torch.bfloat16) * 1.6)(De, D)),
        "w_u": _w((lambda *s: torch.randn(*s, dtype=torch.bfloat16) * 0.05)(D, D)),
        "w_v": _w((lambda *s: torch.randn(*s, dtype=torch.bfloat16) * 0.05)(D, D)),
    }

def reference(x, e_attr, src, dst, w_a, w_b, w_c, w_u, w_v):
    N, D = x.shape
    hv = x @ w_v
    g = x[dst] @ w_a + x[src] @ w_b + e_attr @ w_c
    eta = _sigmoid(g)
    denom = _segment_sum(eta, dst, N) + 1e-6
    eta_n = eta / denom[dst]
    agg = _segment_sum(eta_n * hv[src], dst, N)
    z = x @ w_u + agg
    relu_z = torch.where(z > 0, z, 0 * z)
    return x + relu_z
```

```asm
; @launch kernel=k1_kernel grid=(381,1,1) block=(256,1,1) lds=68608
; @launch kernel=k2_kernel grid=(512,1,1) block=(1024,1,1) lds=79136
.amdgcn_target "amdgcn-amd-amdhsa--gfx950"
.text
.p2align 8
.globl k1_kernel
.type k1_kernel,@function
k1_kernel:
    s_cmp_ge_u32 s2, 381
    s_cbranch_scc1 K1_END2
    s_load_dwordx16 s[16:31], s[0:1], 0
    s_load_dwordx8 s[32:39], s[0:1], 64
    s_cmp_ge_u32 s2, 125
    s_cbranch_scc1 K1_G
K1_PART:
    s_mov_b32 s3, s2
    v_lshlrev_b32 v1, 4, v0
    v_lshlrev_b32 v2, 2, v0
    v_lshlrev_b32 v7, 3, v0
    v_mov_b32 v4, 0
    v_mov_b32 v5, 1
    v_add_u32 v3, 65536, v7
    v_mov_b32 v8, 0
    v_mov_b32 v9, 0
    ds_write_b64 v3, v[8:9]
    v_mov_b32 v6, 67584
    ds_write_b32 v6, v4
    s_mul_i32 s4, s3, 10240
    s_add_u32 s5, s4, 4096
    s_add_u32 s6, s4, 8192
    s_mul_i32 s7, s3, 5120
    s_add_u32 s8, s7, 4096
    s_waitcnt lgkmcnt(0)
    s_barrier
    s_mov_b32 s40, s22
    s_and_b32 s41, s23, 0xffff
    s_mov_b32 s42, 1280000
    s_mov_b32 s43, 0x20000
    buffer_load_dwordx4 v[10:13], v1, s[40:43], s4 offen
    buffer_load_dwordx4 v[14:17], v1, s[40:43], s5 offen
    buffer_load_dwordx2 v[18:19], v7, s[40:43], s6 offen
    s_mov_b32 s44, s20
    s_and_b32 s45, s21, 0xffff
    s_mov_b32 s46, 1280000
    s_mov_b32 s47, 0x20000
    buffer_load_dwordx4 v[20:23], v1, s[44:47], s4 offen
    buffer_load_dwordx4 v[24:27], v1, s[44:47], s5 offen
    buffer_load_dwordx2 v[28:29], v7, s[44:47], s6 offen
    s_mov_b32 s48, s18
    s_and_b32 s49, s19, 0xffff
    s_mov_b32 s50, 640000
    s_mov_b32 s51, 0x20000
    buffer_load_dwordx2 v[30:31], v7, s[48:51], s7 offen
    buffer_load_dwordx2 v[32:33], v7, s[48:51], s7 offen offset:2048
    buffer_load_dword v34, v2, s[48:51], s8 offen
    s_add_u32 s52, s38, 10264576
    s_addc_u32 s53, s39, 0
    s_and_b32 s53, s53, 0xffff
    s_mov_b32 s54, 16777216
    s_mov_b32 s55, 0x20000
    s_add_u32 s60, s38, 27041792
    s_addc_u32 s61, s39, 0
    s_and_b32 s61, s61, 0xffff
    s_mov_b32 s62, 5120000
    s_mov_b32 s63, 0x20000
    s_mov_b32 s9, 219902336
    s_movk_i32 s10, 625
    s_mov_b32 s13, 0xffff0000
    s_waitcnt vmcnt(6)
    v_mul_hi_u32 v40, v10, s9
    v_lshlrev_b32 v50, 2, v40
    v_add_u32 v50, 65536, v50
    ds_add_rtn_u32 v60, v50, v5
    v_mul_hi_u32 v41, v11, s9
    v_lshlrev_b32 v51, 2, v41
    v_add_u32 v51, 65536, v51
    ds_add_rtn_u32 v61, v51, v5
    v_mul_hi_u32 v42, v12, s9
    v_lshlrev_b32 v52, 2, v42
    v_add_u32 v52, 65536, v52
    ds_add_rtn_u32 v62, v52, v5
    v_mul_hi_u32 v43, v13, s9
    v_lshlrev_b32 v53, 2, v43
    v_add_u32 v53, 65536, v53
    ds_add_rtn_u32 v63, v53, v5
    v_mul_hi_u32 v44, v14, s9
    v_lshlrev_b32 v54, 2, v44
    v_add_u32 v54, 65536, v54
    ds_add_rtn_u32 v64, v54, v5
    v_mul_hi_u32 v45, v15, s9
    v_lshlrev_b32 v55, 2, v45
    v_add_u32 v55, 65536, v55
    ds_add_rtn_u32 v65, v55, v5
    v_mul_hi_u32 v46, v16, s9
    v_lshlrev_b32 v56, 2, v46
    v_add_u32 v56, 65536, v56
    ds_add_rtn_u32 v66, v56, v5
    v_mul_hi_u32 v47, v17, s9
    v_lshlrev_b32 v57, 2, v47
    v_add_u32 v57, 65536, v57
    ds_add_rtn_u32 v67, v57, v5
    v_mul_hi_u32 v48, v18, s9
    v_lshlrev_b32 v58, 2, v48
    v_add_u32 v58, 65536, v58
    ds_add_rtn_u32 v68, v58, v5
    v_mul_hi_u32 v49, v19, s9
    v_lshlrev_b32 v59, 2, v49
    v_add_u32 v59, 65536, v59
    ds_add_rtn_u32 v69, v59, v5
    v_mul_lo_u32 v50, v40, s10
    v_add_u32 v50, 31, v50
    v_lshrrev_b32 v50, 5, v50
    v_sub_u32 v10, v10, v50
    v_mul_lo_u32 v51, v41, s10
    v_add_u32 v51, 31, v51
    v_lshrrev_b32 v51, 5, v51
    v_sub_u32 v11, v11, v51
    v_mul_lo_u32 v52, v42, s10
    v_add_u32 v52, 31, v52
    v_lshrrev_b32 v52, 5, v52
    v_sub_u32 v12, v12, v52
    v_mul_lo_u32 v53, v43, s10
    v_add_u32 v53, 31, v53
    v_lshrrev_b32 v53, 5, v53
    v_sub_u32 v13, v13, v53
    v_mul_lo_u32 v54, v44, s10
    v_add_u32 v54, 31, v54
    v_lshrrev_b32 v54, 5, v54
    v_sub_u32 v14, v14, v54
    v_mul_lo_u32 v55, v45, s10
    v_add_u32 v55, 31, v55
    v_lshrrev_b32 v55, 5, v55
    v_sub_u32 v15, v15, v55
    v_mul_lo_u32 v56, v46, s10
    v_add_u32 v56, 31, v56
    v_lshrrev_b32 v56, 5, v56
    v_sub_u32 v16, v16, v56
    v_mul_lo_u32 v57, v47, s10
    v_add_u32 v57, 31, v57
    v_lshrrev_b32 v57, 5, v57
    v_sub_u32 v17, v17, v57
    v_mul_lo_u32 v58, v48, s10
    v_add_u32 v58, 31, v58
    v_lshrrev_b32 v58, 5, v58
    v_sub_u32 v18, v18, v58
    v_mul_lo_u32 v59, v49, s10
    v_add_u32 v59, 31, v59
    v_lshrrev_b32 v59, 5, v59
    v_sub_u32 v19, v19, v59
    s_waitcnt vmcnt(0)
    v_lshlrev_b32 v84, 9, v20
    v_lshlrev_b32 v10, 2, v10
    v_lshl_or_b32 v85, v30, 16, v10
    v_lshlrev_b32 v86, 9, v21
    v_lshlrev_b32 v11, 2, v11
    v_and_or_b32 v87, v30, s13, v11
    v_lshlrev_b32 v88, 9, v22
    v_lshlrev_b32 v12, 2, v12
    v_lshl_or_b32 v89, v31, 16, v12
    v_lshlrev_b32 v90, 9, v23
    v_lshlrev_b32 v13, 2, v13
    v_and_or_b32 v91, v31, s13, v13
    v_lshlrev_b32 v92, 9, v24
    v_lshlrev_b32 v14, 2, v14
    v_lshl_or_b32 v93, v32, 16, v14
    v_lshlrev_b32 v94, 9, v25
    v_lshlrev_b32 v15, 2, v15
    v_and_or_b32 v95, v32, s13, v15
    v_lshlrev_b32 v96, 9, v26
    v_lshlrev_b32 v16, 2, v16
    v_lshl_or_b32 v97, v33, 16, v16
    v_lshlrev_b32 v98, 9, v27
    v_lshlrev_b32 v17, 2, v17
    v_and_or_b32 v99, v33, s13, v17
    v_lshlrev_b32 v100, 9, v28
    v_lshlrev_b32 v18, 2, v18
    v_lshl_or_b32 v101, v34, 16, v18
    v_lshlrev_b32 v102, 9, v29
    v_lshlrev_b32 v19, 2, v19
    v_and_or_b32 v103, v34, s13, v19
    s_mov_b64 s[22:23], exec
    s_mov_b64 s[20:21], 0
    s_waitcnt lgkmcnt(0)
    v_lshlrev_b32 v50, 7, v40
    v_lshl_add_u32 v50, v60, 3, v50
    v_cmp_gt_u32 vcc, 15, v60
    s_andn2_b64 s[24:25], exec, vcc
    s_or_b64 s[20:21], s[20:21], s[24:25]
    s_mov_b64 exec, vcc
    ds_write_b64 v50, v[84:85] offset:8
    s_mov_b64 exec, s[22:23]
    v_lshlrev_b32 v51, 7, v41
    v_lshl_add_u32 v51, v61, 3, v51
    v_cmp_gt_u32 vcc, 15, v61
    s_andn2_b64 s[24:25], exec, vcc
    s_or_b64 s[20:21], s[20:21], s[24:25]
    s_mov_b64 exec, vcc
    ds_write_b64 v51, v[86:87] offset:8
    s_mov_b64 exec, s[22:23]
    v_lshlrev_b32 v52, 7, v42
    v_lshl_add_u32 v52, v62, 3, v52
    v_cmp_gt_u32 vcc, 15, v62
    s_andn2_b64 s[24:25], exec, vcc
    s_or_b64 s[20:21], s[20:21], s[24:25]
    s_mov_b64 exec, vcc
    ds_write_b64 v52, v[88:89] offset:8
    s_mov_b64 exec, s[22:23]
    v_lshlrev_b32 v53, 7, v43
    v_lshl_add_u32 v53, v63, 3, v53
    v_cmp_gt_u32 vcc, 15, v63
    s_andn2_b64 s[24:25], exec, vcc
    s_or_b64 s[20:21], s[20:21], s[24:25]
    s_mov_b64 exec, vcc
    ds_write_b64 v53, v[90:91] offset:8
    s_mov_b64 exec, s[22:23]
    v_lshlrev_b32 v54, 7, v44
    v_lshl_add_u32 v54, v64, 3, v54
    v_cmp_gt_u32 vcc, 15, v64
    s_andn2_b64 s[24:25], exec, vcc
    s_or_b64 s[20:21], s[20:21], s[24:25]
    s_mov_b64 exec, vcc
    ds_write_b64 v54, v[92:93] offset:8
    s_mov_b64 exec, s[22:23]
    v_lshlrev_b32 v55, 7, v45
    v_lshl_add_u32 v55, v65, 3, v55
    v_cmp_gt_u32 vcc, 15, v65
    s_andn2_b64 s[24:25], exec, vcc
    s_or_b64 s[20:21], s[20:21], s[24:25]
    s_mov_b64 exec, vcc
    ds_write_b64 v55, v[94:95] offset:8
    s_mov_b64 exec, s[22:23]
    v_lshlrev_b32 v56, 7, v46
    v_lshl_add_u32 v56, v66, 3, v56
    v_cmp_gt_u32 vcc, 15, v66
    s_andn2_b64 s[24:25], exec, vcc
    s_or_b64 s[20:21], s[20:21], s[24:25]
    s_mov_b64 exec, vcc
    ds_write_b64 v56, v[96:97] offset:8
    s_mov_b64 exec, s[22:23]
    v_lshlrev_b32 v57, 7, v47
    v_lshl_add_u32 v57, v67, 3, v57
    v_cmp_gt_u32 vcc, 15, v67
    s_andn2_b64 s[24:25], exec, vcc
    s_or_b64 s[20:21], s[20:21], s[24:25]
    s_mov_b64 exec, vcc
    ds_write_b64 v57, v[98:99] offset:8
    s_mov_b64 exec, s[22:23]
    v_lshlrev_b32 v58, 7, v48
    v_lshl_add_u32 v58, v68, 3, v58
    v_cmp_gt_u32 vcc, 15, v68
    s_andn2_b64 s[24:25], exec, vcc
    s_or_b64 s[20:21], s[20:21], s[24:25]
    s_mov_b64 exec, vcc
    ds_write_b64 v58, v[100:101] offset:8
    s_mov_b64 exec, s[22:23]
    v_lshlrev_b32 v59, 7, v49
    v_lshl_add_u32 v59, v69, 3, v59
    v_cmp_gt_u32 vcc, 15, v69
    s_andn2_b64 s[24:25], exec, vcc
    s_or_b64 s[20:21], s[20:21], s[24:25]
    s_mov_b64 exec, vcc
    ds_write_b64 v59, v[102:103] offset:8
    s_mov_b64 exec, s[22:23]
    s_cmp_eq_u64 s[20:21], 0
    s_cbranch_scc1 K1_NOOVF
    s_mul_i32 s11, s3, 40960
    s_lshl_b32 s12, s3, 7
    s_add_u32 s12, s12, 16264
    v_cmp_le_u32 vcc, 15, v60
    v_cmp_gt_u32 s[24:25], 31, v60
    s_and_b64 s[26:27], vcc, s[24:25]
    s_mov_b64 exec, s[26:27]
    s_cbranch_execz K1_OW0
    v_lshlrev_b32 v70, 15, v40
    v_lshl_add_u32 v70, v60, 3, v70
    buffer_store_dwordx2 v[84:85], v70, s[52:55], s12 offen
K1_OW0:
    s_andn2_b64 exec, s[22:23], s[24:25]
    s_cbranch_execz K1_OV0
    ds_add_rtn_u32 v70, v6, v5
    v_mov_b32 v72, v84
    v_mov_b32 v73, v85
    v_mov_b32 v74, v40
    v_mov_b32 v75, 0
    s_waitcnt lgkmcnt(0)
    v_lshlrev_b32 v70, 4, v70
    buffer_store_dwordx4 v[72:75], v70, s[60:63], s11 offen
K1_OV0:
    s_mov_b64 exec, s[22:23]
    v_cmp_le_u32 vcc, 15, v61
    v_cmp_gt_u32 s[24:25], 31, v61
    s_and_b64 s[26:27], vcc, s[24:25]
    s_mov_b64 exec, s[26:27]
    s_cbranch_execz K1_OW1
    v_lshlrev_b32 v70, 15, v41
    v_lshl_add_u32 v70, v61, 3, v70
    buffer_store_dwordx2 v[86:87], v70, s[52:55], s12 offen
K1_OW1:
    s_andn2_b64 exec, s[22:23], s[24:25]
    s_cbranch_execz K1_OV1
    ds_add_rtn_u32 v70, v6, v5
    v_mov_b32 v72, v86
    v_mov_b32 v73, v87
    v_mov_b32 v74, v41
    v_mov_b32 v75, 0
    s_waitcnt lgkmcnt(0)
    v_lshlrev_b32 v70, 4, v70
    buffer_store_dwordx4 v[72:75], v70, s[60:63], s11 offen
K1_OV1:
    s_mov_b64 exec, s[22:23]
    v_cmp_le_u32 vcc, 15, v62
    v_cmp_gt_u32 s[24:25], 31, v62
    s_and_b64 s[26:27], vcc, s[24:25]
    s_mov_b64 exec, s[26:27]
    s_cbranch_execz K1_OW2
    v_lshlrev_b32 v70, 15, v42
    v_lshl_add_u32 v70, v62, 3, v70
    buffer_store_dwordx2 v[88:89], v70, s[52:55], s12 offen
K1_OW2:
    s_andn2_b64 exec, s[22:23], s[24:25]
    s_cbranch_execz K1_OV2
    ds_add_rtn_u32 v70, v6, v5
    v_mov_b32 v72, v88
    v_mov_b32 v73, v89
    v_mov_b32 v74, v42
    v_mov_b32 v75, 0
    s_waitcnt lgkmcnt(0)
    v_lshlrev_b32 v70, 4, v70
    buffer_store_dwordx4 v[72:75], v70, s[60:63], s11 offen
K1_OV2:
    s_mov_b64 exec, s[22:23]
    v_cmp_le_u32 vcc, 15, v63
    v_cmp_gt_u32 s[24:25], 31, v63
    s_and_b64 s[26:27], vcc, s[24:25]
    s_mov_b64 exec, s[26:27]
    s_cbranch_execz K1_OW3
    v_lshlrev_b32 v70, 15, v43
    v_lshl_add_u32 v70, v63, 3, v70
    buffer_store_dwordx2 v[90:91], v70, s[52:55], s12 offen
K1_OW3:
    s_andn2_b64 exec, s[22:23], s[24:25]
    s_cbranch_execz K1_OV3
    ds_add_rtn_u32 v70, v6, v5
    v_mov_b32 v72, v90
    v_mov_b32 v73, v91
    v_mov_b32 v74, v43
    v_mov_b32 v75, 0
    s_waitcnt lgkmcnt(0)
    v_lshlrev_b32 v70, 4, v70
    buffer_store_dwordx4 v[72:75], v70, s[60:63], s11 offen
K1_OV3:
    s_mov_b64 exec, s[22:23]
    v_cmp_le_u32 vcc, 15, v64
    v_cmp_gt_u32 s[24:25], 31, v64
    s_and_b64 s[26:27], vcc, s[24:25]
    s_mov_b64 exec, s[26:27]
    s_cbranch_execz K1_OW4
    v_lshlrev_b32 v70, 15, v44
    v_lshl_add_u32 v70, v64, 3, v70
    buffer_store_dwordx2 v[92:93], v70, s[52:55], s12 offen
K1_OW4:
    s_andn2_b64 exec, s[22:23], s[24:25]
    s_cbranch_execz K1_OV4
    ds_add_rtn_u32 v70, v6, v5
    v_mov_b32 v72, v92
    v_mov_b32 v73, v93
    v_mov_b32 v74, v44
    v_mov_b32 v75, 0
    s_waitcnt lgkmcnt(0)
    v_lshlrev_b32 v70, 4, v70
    buffer_store_dwordx4 v[72:75], v70, s[60:63], s11 offen
K1_OV4:
    s_mov_b64 exec, s[22:23]
    v_cmp_le_u32 vcc, 15, v65
    v_cmp_gt_u32 s[24:25], 31, v65
    s_and_b64 s[26:27], vcc, s[24:25]
    s_mov_b64 exec, s[26:27]
    s_cbranch_execz K1_OW5
    v_lshlrev_b32 v70, 15, v45
    v_lshl_add_u32 v70, v65, 3, v70
    buffer_store_dwordx2 v[94:95], v70, s[52:55], s12 offen
K1_OW5:
    s_andn2_b64 exec, s[22:23], s[24:25]
    s_cbranch_execz K1_OV5
    ds_add_rtn_u32 v70, v6, v5
    v_mov_b32 v72, v94
    v_mov_b32 v73, v95
    v_mov_b32 v74, v45
    v_mov_b32 v75, 0
    s_waitcnt lgkmcnt(0)
    v_lshlrev_b32 v70, 4, v70
    buffer_store_dwordx4 v[72:75], v70, s[60:63], s11 offen
K1_OV5:
    s_mov_b64 exec, s[22:23]
    v_cmp_le_u32 vcc, 15, v66
    v_cmp_gt_u32 s[24:25], 31, v66
    s_and_b64 s[26:27], vcc, s[24:25]
    s_mov_b64 exec, s[26:27]
    s_cbranch_execz K1_OW6
    v_lshlrev_b32 v70, 15, v46
    v_lshl_add_u32 v70, v66, 3, v70
    buffer_store_dwordx2 v[96:97], v70, s[52:55], s12 offen
K1_OW6:
    s_andn2_b64 exec, s[22:23], s[24:25]
    s_cbranch_execz K1_OV6
    ds_add_rtn_u32 v70, v6, v5
    v_mov_b32 v72, v96
    v_mov_b32 v73, v97
    v_mov_b32 v74, v46
    v_mov_b32 v75, 0
    s_waitcnt lgkmcnt(0)
    v_lshlrev_b32 v70, 4, v70
    buffer_store_dwordx4 v[72:75], v70, s[60:63], s11 offen
K1_OV6:
    s_mov_b64 exec, s[22:23]
    v_cmp_le_u32 vcc, 15, v67
    v_cmp_gt_u32 s[24:25], 31, v67
    s_and_b64 s[26:27], vcc, s[24:25]
    s_mov_b64 exec, s[26:27]
    s_cbranch_execz K1_OW7
    v_lshlrev_b32 v70, 15, v47
    v_lshl_add_u32 v70, v67, 3, v70
    buffer_store_dwordx2 v[98:99], v70, s[52:55], s12 offen
K1_OW7:
    s_andn2_b64 exec, s[22:23], s[24:25]
    s_cbranch_execz K1_OV7
    ds_add_rtn_u32 v70, v6, v5
    v_mov_b32 v72, v98
    v_mov_b32 v73, v99
    v_mov_b32 v74, v47
    v_mov_b32 v75, 0
    s_waitcnt lgkmcnt(0)
    v_lshlrev_b32 v70, 4, v70
    buffer_store_dwordx4 v[72:75], v70, s[60:63], s11 offen
K1_OV7:
    s_mov_b64 exec, s[22:23]
    v_cmp_le_u32 vcc, 15, v68
    v_cmp_gt_u32 s[24:25], 31, v68
    s_and_b64 s[26:27], vcc, s[24:25]
    s_mov_b64 exec, s[26:27]
    s_cbranch_execz K1_OW8
    v_lshlrev_b32 v70, 15, v48
    v_lshl_add_u32 v70, v68, 3, v70
    buffer_store_dwordx2 v[100:101], v70, s[52:55], s12 offen
K1_OW8:
    s_andn2_b64 exec, s[22:23], s[24:25]
    s_cbranch_execz K1_OV8
    ds_add_rtn_u32 v70, v6, v5
    v_mov_b32 v72, v100
    v_mov_b32 v73, v101
    v_mov_b32 v74, v48
    v_mov_b32 v75, 0
    s_waitcnt lgkmcnt(0)
    v_lshlrev_b32 v70, 4, v70
    buffer_store_dwordx4 v[72:75], v70, s[60:63], s11 offen
K1_OV8:
    s_mov_b64 exec, s[22:23]
    v_cmp_le_u32 vcc, 15, v69
    v_cmp_gt_u32 s[24:25], 31, v69
    s_and_b64 s[26:27], vcc, s[24:25]
    s_mov_b64 exec, s[26:27]
    s_cbranch_execz K1_OW9
    v_lshlrev_b32 v70, 15, v49
    v_lshl_add_u32 v70, v69, 3, v70
    buffer_store_dwordx2 v[102:103], v70, s[52:55], s12 offen
K1_OW9:
    s_andn2_b64 exec, s[22:23], s[24:25]
    s_cbranch_execz K1_OV9
    ds_add_rtn_u32 v70, v6, v5
    v_mov_b32 v72, v102
    v_mov_b32 v73, v103
    v_mov_b32 v74, v49
    v_mov_b32 v75, 0
    s_waitcnt lgkmcnt(0)
    v_lshlrev_b32 v70, 4, v70
    buffer_store_dwordx4 v[72:75], v70, s[60:63], s11 offen
K1_OV9:
    s_mov_b64 exec, s[22:23]
K1_NOOVF:
    s_waitcnt lgkmcnt(0)
    s_barrier
    v_lshrrev_b32 v12, 3, v0
    v_and_b32 v13, 7, v0
    v_lshlrev_b32 v14, 2, v12
    v_add_u32 v14, 65536, v14
    v_lshlrev_b32 v16, 4, v0
    v_lshlrev_b32 v15, 15, v12
    v_lshl_add_u32 v15, v13, 4, v15
    s_lshl_b32 s11, s3, 7
    ds_read_b32 v17, v6
    v_cmp_eq_u32 s[24:25], 0, v13
    v_lshlrev_b32 v13, 1, v13
    ds_read_b32 v20, v14 offset:0
    ds_read_b32 v21, v14 offset:128
    ds_read_b32 v22, v14 offset:256
    ds_read_b32 v23, v14 offset:384
    ds_read_b32 v24, v14 offset:512
    ds_read_b32 v25, v14 offset:640
    ds_read_b32 v26, v14 offset:768
    ds_read_b32 v27, v14 offset:896
    ds_read_b128 v[40:43], v16 offset:0
    ds_read_b128 v[44:47], v16 offset:4096
    ds_read_b128 v[48:51], v16 offset:8192
    ds_read_b128 v[52:55], v16 offset:12288
    ds_read_b128 v[56:59], v16 offset:16384
    ds_read_b128 v[60:63], v16 offset:20480
    ds_read_b128 v[64:67], v16 offset:24576
    ds_read_b128 v[68:71], v16 offset:28672
    s_waitcnt lgkmcnt(7)
    v_cndmask_b32 v40, v40, v20, s[24:25]
    v_cndmask_b32 v41, v41, v17, s[24:25]
    v_cmp_le_u32 vcc, v13, v20
    s_mov_b64 exec, vcc
    buffer_store_dwordx4 v[40:43], v15, s[52:55], s11 offen
    s_mov_b64 exec, s[22:23]
    s_add_u32 s11, s11, 1048576
    s_waitcnt lgkmcnt(6)
    v_cndmask_b32 v44, v44, v21, s[24:25]
    v_cndmask_b32 v45, v45, v17, s[24:25]
    v_cmp_le_u32 vcc, v13, v21
    s_mov_b64 exec, vcc
    buffer_store_dwordx4 v[44:47], v15, s[52:55], s11 offen
    s_mov_b64 exec, s[22:23]
    s_add_u32 s11, s11, 1048576
    s_waitcnt lgkmcnt(5)
    v_cndmask_b32 v48, v48, v22, s[24:25]
    v_cndmask_b32 v49, v49, v17, s[24:25]
    v_cmp_le_u32 vcc, v13, v22
    s_mov_b64 exec, vcc
    buffer_store_dwordx4 v[48:51], v15, s[52:55], s11 offen
    s_mov_b64 exec, s[22:23]
    s_add_u32 s11, s11, 1048576
    s_waitcnt lgkmcnt(4)
    v_cndmask_b32 v52, v52, v23, s[24:25]
    v_cndmask_b32 v53, v53, v17, s[24:25]
    v_cmp_le_u32 vcc, v13, v23
    s_mov_b64 exec, vcc
    buffer_store_dwordx4 v[52:55], v15, s[52:55], s11 offen
    s_mov_b64 exec, s[22:23]
    s_add_u32 s11, s11, 1048576
    s_waitcnt lgkmcnt(3)
    v_cndmask_b32 v56, v56, v24, s[24:25]
    v_cndmask_b32 v57, v57, v17, s[24:25]
    v_cmp_le_u32 vcc, v13, v24
    s_mov_b64 exec, vcc
    buffer_store_dwordx4 v[56:59], v15, s[52:55], s11 offen
    s_mov_b64 exec, s[22:23]
    s_add_u32 s11, s11, 1048576
    s_waitcnt lgkmcnt(2)
    v_cndmask_b32 v60, v60, v25, s[24:25]
    v_cndmask_b32 v61, v61, v17, s[24:25]
    v_cmp_le_u32 vcc, v13, v25
    s_mov_b64 exec, vcc
    buffer_store_dwordx4 v[60:63], v15, s[52:55], s11 offen
    s_mov_b64 exec, s[22:23]
    s_add_u32 s11, s11, 1048576
    s_waitcnt lgkmcnt(1)
    v_cndmask_b32 v64, v64, v26, s[24:25]
    v_cndmask_b32 v65, v65, v17, s[24:25]
    v_cmp_le_u32 vcc, v13, v26
    s_mov_b64 exec, vcc
    buffer_store_dwordx4 v[64:67], v15, s[52:55], s11 offen
    s_mov_b64 exec, s[22:23]
    s_add_u32 s11, s11, 1048576
    s_waitcnt lgkmcnt(0)
    v_cndmask_b32 v68, v68, v27, s[24:25]
    v_cndmask_b32 v69, v69, v17, s[24:25]
    v_cmp_le_u32 vcc, v13, v27
    s_mov_b64 exec, vcc
    buffer_store_dwordx4 v[68:71], v15, s[52:55], s11 offen
    s_mov_b64 exec, s[22:23]
    s_add_u32 s11, s11, 1048576
    s_nop 1
    ds_read_b32 v20, v14 offset:1024
    ds_read_b32 v21, v14 offset:1152
    ds_read_b32 v22, v14 offset:1280
    ds_read_b32 v23, v14 offset:1408
    ds_read_b32 v24, v14 offset:1536
    ds_read_b32 v25, v14 offset:1664
    ds_read_b32 v26, v14 offset:1792
    ds_read_b32 v27, v14 offset:1920
    ds_read_b128 v[40:43], v16 offset:32768
    ds_read_b128 v[44:47], v16 offset:36864
    ds_read_b128 v[48:51], v16 offset:40960
    ds_read_b128 v[52:55], v16 offset:45056
    ds_read_b128 v[56:59], v16 offset:49152
    ds_read_b128 v[60:63], v16 offset:53248
    ds_read_b128 v[64:67], v16 offset:57344
    ds_read_b128 v[68:71], v16 offset:61440
    s_waitcnt lgkmcnt(7)
    v_cndmask_b32 v40, v40, v20, s[24:25]
    v_cndmask_b32 v41, v41, v17, s[24:25]
    v_cmp_le_u32 vcc, v13, v20
    s_mov_b64 exec, vcc
    buffer_store_dwordx4 v[40:43], v15, s[52:55], s11 offen
    s_mov_b64 exec, s[22:23]
    s_add_u32 s11, s11, 1048576
    s_waitcnt lgkmcnt(6)
    v_cndmask_b32 v44, v44, v21, s[24:25]
    v_cndmask_b32 v45, v45, v17, s[24:25]
    v_cmp_le_u32 vcc, v13, v21
    s_mov_b64 exec, vcc
    buffer_store_dwordx4 v[44:47], v15, s[52:55], s11 offen
    s_mov_b64 exec, s[22:23]
    s_add_u32 s11, s11, 1048576
    s_waitcnt lgkmcnt(5)
    v_cndmask_b32 v48, v48, v22, s[24:25]
    v_cndmask_b32 v49, v49, v17, s[24:25]
    v_cmp_le_u32 vcc, v13, v22
    s_mov_b64 exec, vcc
    buffer_store_dwordx4 v[48:51], v15, s[52:55], s11 offen
    s_mov_b64 exec, s[22:23]
    s_add_u32 s11, s11, 1048576
    s_waitcnt lgkmcnt(4)
    v_cndmask_b32 v52, v52, v23, s[24:25]
    v_cndmask_b32 v53, v53, v17, s[24:25]
    v_cmp_le_u32 vcc, v13, v23
    s_mov_b64 exec, vcc
    buffer_store_dwordx4 v[52:55], v15, s[52:55], s11 offen
    s_mov_b64 exec, s[22:23]
    s_add_u32 s11, s11, 1048576
    s_waitcnt lgkmcnt(3)
    v_cndmask_b32 v56, v56, v24, s[24:25]
    v_cndmask_b32 v57, v57, v17, s[24:25]
    v_cmp_le_u32 vcc, v13, v24
    s_mov_b64 exec, vcc
    buffer_store_dwordx4 v[56:59], v15, s[52:55], s11 offen
    s_mov_b64 exec, s[22:23]
    s_add_u32 s11, s11, 1048576
    s_waitcnt lgkmcnt(2)
    v_cndmask_b32 v60, v60, v25, s[24:25]
    v_cndmask_b32 v61, v61, v17, s[24:25]
    v_cmp_le_u32 vcc, v13, v25
    s_mov_b64 exec, vcc
    buffer_store_dwordx4 v[60:63], v15, s[52:55], s11 offen
    s_mov_b64 exec, s[22:23]
    s_add_u32 s11, s11, 1048576
    s_waitcnt lgkmcnt(1)
    v_cndmask_b32 v64, v64, v26, s[24:25]
    v_cndmask_b32 v65, v65, v17, s[24:25]
    v_cmp_le_u32 vcc, v13, v26
    s_mov_b64 exec, vcc
    buffer_store_dwordx4 v[64:67], v15, s[52:55], s11 offen
    s_mov_b64 exec, s[22:23]
    s_add_u32 s11, s11, 1048576
    s_waitcnt lgkmcnt(0)
    v_cndmask_b32 v68, v68, v27, s[24:25]
    v_cndmask_b32 v69, v69, v17, s[24:25]
    v_cmp_le_u32 vcc, v13, v27
    s_mov_b64 exec, vcc
    buffer_store_dwordx4 v[68:71], v15, s[52:55], s11 offen
    s_mov_b64 exec, s[22:23]
    s_add_u32 s11, s11, 1048576
    s_branch K1_END
K1_G:
    v_and_b32 v1, 63, v0
    v_lshrrev_b32 v2, 6, v0
    v_and_b32 v3, 15, v1
    v_readfirstlane_b32 s3, v2
    v_lshrrev_b32 v4, 4, v1
    s_sub_u32 s65, s2, 125
    s_and_b32 s4, s65, 1
    s_lshr_b32 s5, s65, 1
    s_and_b32 s5, s5, 1
    s_lshr_b32 s6, s65, 2
    v_lshlrev_b32 v5, 11, v4
    v_lshl_add_u32 v5, v3, 3, v5
    v_lshlrev_b32 v6, 8, v3
    v_lshl_add_u32 v6, v4, 4, v6
    v_lshlrev_b32 v8, 4, v1
    v_lshlrev_b32 v7, 11, v4
    v_lshl_add_u32 v7, v3, 4, v7
    s_lshl_b32 s7, s6, 2
    s_add_u32 s7, s7, s3
    s_lshl_b32 s8, s7, 12
    s_add_u32 s9, s8, 1048576
    s_add_u32 s10, s8, 2097152
    s_lshl_b32 s11, s3, 13
    s_lshl_b32 s12, s4, 7
    s_add_u32 s11, s11, s12
    s_waitcnt lgkmcnt(0)
    s_cmp_eq_u32 s5, 0
    s_cselect_b32 s44, s26, s30
    s_cselect_b32 s45, s27, s31
    s_cselect_b32 s48, s32, s24
    s_cselect_b32 s49, s33, s25
    s_mov_b32 s60, 0xbfb8aa3b
    s_cselect_b32 s63, s60, 1.0
    s_cselect_b32 s64, 1.0, s60
    s_mov_b32 s12, 5144576
    s_cselect_b32 s12, 0, s12
    s_and_b32 s45, s45, 0xffff
    s_and_b32 s49, s49, 0xffff
    s_mov_b32 s46, 32768
    s_mov_b32 s47, 0x20000
    s_mov_b32 s50, 32768
    s_mov_b32 s51, 0x20000
    s_mov_b32 s40, s16
    s_and_b32 s41, s17, 0xffff
    s_mov_b32 s42, 2560000
    s_mov_b32 s43, 0x20000
    buffer_load_dwordx2 v[64:65], v5, s[44:47], s11 offen offset:0
    buffer_load_dwordx2 v[66:67], v5, s[44:47], s11 offen offset:256
    buffer_load_dwordx2 v[68:69], v5, s[44:47], s11 offen offset:512
    buffer_load_dwordx2 v[70:71], v5, s[44:47], s11 offen offset:768
    buffer_load_dwordx2 v[72:73], v5, s[44:47], s11 offen offset:1024
    buffer_load_dwordx2 v[74:75], v5, s[44:47], s11 offen offset:1280
    buffer_load_dwordx2 v[76:77], v5, s[44:47], s11 offen offset:1536
    buffer_load_dwordx2 v[78:79], v5, s[44:47], s11 offen offset:1792
    buffer_load_dwordx2 v[80:81], v5, s[48:51], s11 offen offset:0
    buffer_load_dwordx2 v[82:83], v5, s[48:51], s11 offen offset:256
    buffer_load_dwordx2 v[84:85], v5, s[48:51], s11 offen offset:512
    buffer_load_dwordx2 v[86:87], v5, s[48:51], s11 offen offset:768
    buffer_load_dwordx2 v[88:89], v5, s[48:51], s11 offen offset:1024
    buffer_load_dwordx2 v[90:91], v5, s[48:51], s11 offen offset:1280
    buffer_load_dwordx2 v[92:93], v5, s[48:51], s11 offen offset:1536
    buffer_load_dwordx2 v[94:95], v5, s[48:51], s11 offen offset:1792
    s_mov_b32 s13, 0x05040100
    s_mov_b32 s14, 0x07060302
    s_mov_b32 s61, 0xffff0000
    s_mov_b32 s62, 0x80000000
    s_lshl_b32 s15, s3, 12
    v_add_u32 v9, s15, v8
    s_lshl_b32 s15, s4, 8
    s_add_u32 s52, s38, s12
    s_addc_u32 s53, s39, 0
    s_add_u32 s52, s52, s15
    s_addc_u32 s53, s53, 0
    s_and_b32 s53, s53, 0xffff
    s_mov_b32 s54, 5120256
    s_mov_b32 s55, 0x20000
    s_waitcnt vmcnt(8)
    buffer_load_dwordx4 v[32:35], v6, s[40:43], s8 offen offset:0
    buffer_load_dwordx4 v[36:39], v6, s[40:43], s8 offen offset:64
    buffer_load_dwordx4 v[40:43], v6, s[40:43], s8 offen offset:128
    buffer_load_dwordx4 v[44:47], v6, s[40:43], s8 offen offset:192
    buffer_load_dwordx4 v[48:51], v6, s[40:43], s9 offen offset:0
    buffer_load_dwordx4 v[52:55], v6, s[40:43], s9 offen offset:64
    buffer_load_dwordx4 v[56:59], v6, s[40:43], s9 offen offset:128
    buffer_load_dwordx4 v[60:63], v6, s[40:43], s9 offen offset:192
    v_perm_b32 v96, v66, v64, s13
    v_perm_b32 v97, v70, v68, s13
    v_perm_b32 v98, v74, v72, s13
    v_perm_b32 v99, v78, v76, s13
    ds_write_b128 v9, v[96:99] offset:0
    v_perm_b32 v100, v66, v64, s14
    v_perm_b32 v101, v70, v68, s14
    v_perm_b32 v102, v74, v72, s14
    v_perm_b32 v103, v78, v76, s14
    ds_write_b128 v9, v[100:103] offset:1024
    v_perm_b32 v104, v67, v65, s13
    v_perm_b32 v105, v71, v69, s13
    v_perm_b32 v106, v75, v73, s13
    v_perm_b32 v107, v79, v77, s13
    ds_write_b128 v9, v[104:107] offset:2048
    v_perm_b32 v108, v67, v65, s14
    v_perm_b32 v109, v71, v69, s14
    v_perm_b32 v110, v75, v73, s14
    v_perm_b32 v111, v79, v77, s14
    ds_write_b128 v9, v[108:111] offset:3072
    s_waitcnt vmcnt(8)
    v_perm_b32 v96, v82, v80, s13
    v_perm_b32 v97, v86, v84, s13
    v_perm_b32 v98, v90, v88, s13
    v_perm_b32 v99, v94, v92, s13
    ds_write_b128 v9, v[96:99] offset:16384
    v_perm_b32 v100, v82, v80, s14
    v_perm_b32 v101, v86, v84, s14
    v_perm_b32 v102, v90, v88, s14
    v_perm_b32 v103, v94, v92, s14
    ds_write_b128 v9, v[100:103] offset:17408
    v_perm_b32 v104, v83, v81, s13
    v_perm_b32 v105, v87, v85, s13
    v_perm_b32 v106, v91, v89, s13
    v_perm_b32 v107, v95, v93, s13
    ds_write_b128 v9, v[104:107] offset:18432
    v_perm_b32 v108, v83, v81, s14
    v_perm_b32 v109, v87, v85, s14
    v_perm_b32 v110, v91, v89, s14
    v_perm_b32 v111, v95, v93, s14
    ds_write_b128 v9, v[108:111] offset:19456
    s_waitcnt lgkmcnt(0)
    s_barrier
    ds_read_b128 v[128:131], v8 offset:0
    ds_read_b128 v[132:135], v8 offset:1024
    ds_read_b128 v[136:139], v8 offset:2048
    ds_read_b128 v[140:143], v8 offset:3072
    ds_read_b128 v[144:147], v8 offset:4096
    ds_read_b128 v[148:151], v8 offset:5120
    ds_read_b128 v[152:155], v8 offset:6144
    ds_read_b128 v[156:159], v8 offset:7168
    ds_read_b128 v[160:163], v8 offset:8192
    ds_read_b128 v[164:167], v8 offset:9216
    ds_read_b128 v[168:171], v8 offset:10240
    ds_read_b128 v[172:175], v8 offset:11264
    ds_read_b128 v[176:179], v8 offset:12288
    ds_read_b128 v[180:183], v8 offset:13312
    ds_read_b128 v[184:187], v8 offset:14336
    ds_read_b128 v[188:191], v8 offset:15360
    ds_read_b128 v[192:195], v8 offset:16384
    ds_read_b128 v[196:199], v8 offset:17408
    ds_read_b128 v[200:203], v8 offset:18432
    ds_read_b128 v[204:207], v8 offset:19456
    ds_read_b128 v[208:211], v8 offset:20480
    ds_read_b128 v[212:215], v8 offset:21504
    ds_read_b128 v[216:219], v8 offset:22528
    ds_read_b128 v[220:223], v8 offset:23552
    ds_read_b128 v[224:227], v8 offset:24576
    ds_read_b128 v[228:231], v8 offset:25600
    ds_read_b128 v[232:235], v8 offset:26624
    ds_read_b128 v[236:239], v8 offset:27648
    ds_read_b128 v[240:243], v8 offset:28672
    ds_read_b128 v[244:247], v8 offset:29696
    ds_read_b128 v[248:251], v8 offset:30720
    ds_read_b128 v[252:255], v8 offset:31744
    s_or_b32 s12, s7, s5
    s_cmp_eq_u32 s12, 0
    s_cbranch_scc0 K1_NODUMMY
    v_mov_b32 v10, 0x7f80
    v_lshlrev_b32 v11, 2, v1
    s_mov_b32 s12, 5120000
    buffer_store_dword v10, v11, s[52:55], s12 offen
K1_NODUMMY:
    s_waitcnt vmcnt(4) lgkmcnt(0)
    v_mfma_f32_16x16x32_bf16 v[96:99], v[32:35], v[128:131], 0
    v_mfma_f32_16x16x32_bf16 v[100:103], v[32:35], v[132:135], 0
    v_mfma_f32_16x16x32_bf16 v[112:115], v[32:35], v[192:195], 0
    v_mfma_f32_16x16x32_bf16 v[116:119], v[32:35], v[196:199], 0
    v_mfma_f32_16x16x32_bf16 v[96:99], v[36:39], v[144:147], v[96:99]
    v_mfma_f32_16x16x32_bf16 v[100:103], v[36:39], v[148:151], v[100:103]
    v_mfma_f32_16x16x32_bf16 v[112:115], v[36:39], v[208:211], v[112:115]
    v_mfma_f32_16x16x32_bf16 v[116:119], v[36:39], v[212:215], v[116:119]
    v_mfma_f32_16x16x32_bf16 v[96:99], v[40:43], v[160:163], v[96:99]
    v_mfma_f32_16x16x32_bf16 v[100:103], v[40:43], v[164:167], v[100:103]
    v_mfma_f32_16x16x32_bf16 v[112:115], v[40:43], v[224:227], v[112:115]
    v_mfma_f32_16x16x32_bf16 v[116:119], v[40:43], v[228:231], v[116:119]
    v_mfma_f32_16x16x32_bf16 v[96:99], v[44:47], v[176:179], v[96:99]
    v_mfma_f32_16x16x32_bf16 v[100:103], v[44:47], v[180:183], v[100:103]
    v_mfma_f32_16x16x32_bf16 v[112:115], v[44:47], v[240:243], v[112:115]
    v_mfma_f32_16x16x32_bf16 v[116:119], v[44:47], v[244:247], v[116:119]
    s_waitcnt vmcnt(0)
K1_TILE:
    v_mfma_f32_16x16x32_bf16 v[104:107], v[32:35], v[136:139], 0
    v_mfma_f32_16x16x32_bf16 v[108:111], v[32:35], v[140:143], 0
    s_nop 7
    v_mul_f32 v80, s63, v96
    v_mul_f32 v82, s64, v112
    v_cvt_pk_bf16_f32 v81, v80, 0
    v_and_b32 v64, 0x7fffffff, v82
    v_add_u32 v64, 0x8000, v64
    v_mfma_f32_16x16x32_bf16 v[120:123], v[32:35], v[200:203], 0
    v_sub_u32 v64, v64, v81
    v_max_i32 v64, 0, v64
    v_and_or_b32 v64, v64, s61, v81
    v_and_or_b32 v64, v82, s62, v64
    v_mul_f32 v84, s63, v100
    v_mfma_f32_16x16x32_bf16 v[124:127], v[32:35], v[204:207], 0
    v_mul_f32 v86, s64, v116
    v_cvt_pk_bf16_f32 v85, v84, 0
    v_and_b32 v65, 0x7fffffff, v86
    v_add_u32 v65, 0x8000, v65
    v_sub_u32 v65, v65, v85
    v_mfma_f32_16x16x32_bf16 v[104:107], v[36:39], v[152:155], v[104:107]
    v_max_i32 v65, 0, v65
    v_and_or_b32 v65, v65, s61, v85
    v_and_or_b32 v65, v86, s62, v65
    v_mul_f32 v80, s63, v97
    v_mul_f32 v82, s64, v113
    v_mfma_f32_16x16x32_bf16 v[108:111], v[36:39], v[156:159], v[108:111]
    v_cvt_pk_bf16_f32 v81, v80, 0
    v_and_b32 v68, 0x7fffffff, v82
    v_add_u32 v68, 0x8000, v68
    v_sub_u32 v68, v68, v81
    v_max_i32 v68, 0, v68
    v_mfma_f32_16x16x32_bf16 v[120:123], v[36:39], v[216:219], v[120:123]
    v_and_or_b32 v68, v68, s61, v81
    v_and_or_b32 v68, v82, s62, v68
    v_mul_f32 v84, s63, v101
    v_mul_f32 v86, s64, v117
    v_cvt_pk_bf16_f32 v85, v84, 0
    v_mfma_f32_16x16x32_bf16 v[124:127], v[36:39], v[220:223], v[124:127]
    v_and_b32 v69, 0x7fffffff, v86
    v_add_u32 v69, 0x8000, v69
    v_sub_u32 v69, v69, v85
    v_max_i32 v69, 0, v69
    v_and_or_b32 v69, v69, s61, v85
    v_mfma_f32_16x16x32_bf16 v[104:107], v[40:43], v[168:171], v[104:107]
    v_and_or_b32 v69, v86, s62, v69
    v_mul_f32 v80, s63, v98
    v_mul_f32 v82, s64, v114
    v_cvt_pk_bf16_f32 v81, v80, 0
    v_and_b32 v72, 0x7fffffff, v82
    v_mfma_f32_16x16x32_bf16 v[108:111], v[40:43], v[172:175], v[108:111]
    v_add_u32 v72, 0x8000, v72
    v_sub_u32 v72, v72, v81
    v_max_i32 v72, 0, v72
    v_and_or_b32 v72, v72, s61, v81
    v_and_or_b32 v72, v82, s62, v72
    v_mfma_f32_16x16x32_bf16 v[120:123], v[40:43], v[232:235], v[120:123]
    v_mul_f32 v84, s63, v102
    v_mul_f32 v86, s64, v118
    v_cvt_pk_bf16_f32 v85, v84, 0
    v_and_b32 v73, 0x7fffffff, v86
    v_add_u32 v73, 0x8000, v73
    v_mfma_f32_16x16x32_bf16 v[124:127], v[40:43], v[236:239], v[124:127]
    v_sub_u32 v73, v73, v85
    v_max_i32 v73, 0, v73
    v_and_or_b32 v73, v73, s61, v85
    v_and_or_b32 v73, v86, s62, v73
    v_mul_f32 v80, s63, v99
    v_mfma_f32_16x16x32_bf16 v[104:107], v[44:47], v[184:187], v[104:107]
    v_mul_f32 v82, s64, v115
    v_cvt_pk_bf16_f32 v81, v80, 0
    v_and_b32 v76, 0x7fffffff, v82
    v_add_u32 v76, 0x8000, v76
    v_sub_u32 v76, v76, v81
    v_mfma_f32_16x16x32_bf16 v[108:111], v[44:47], v[188:191], v[108:111]
    v_max_i32 v76, 0, v76
    v_and_or_b32 v76, v76, s61, v81
    v_and_or_b32 v76, v82, s62, v76
    v_mul_f32 v84, s63, v103
    v_mul_f32 v86, s64, v119
    v_mfma_f32_16x16x32_bf16 v[120:123], v[44:47], v[248:251], v[120:123]
    v_cvt_pk_bf16_f32 v85, v84, 0
    v_and_b32 v77, 0x7fffffff, v86
    v_add_u32 v77, 0x8000, v77
    v_sub_u32 v77, v77, v85
    v_max_i32 v77, 0, v77
    v_mfma_f32_16x16x32_bf16 v[124:127], v[44:47], v[252:255], v[124:127]
    v_and_or_b32 v77, v77, s61, v85
    v_and_or_b32 v77, v86, s62, v77
    s_waitcnt vmcnt(4)
    v_mov_b32 v32, v48
    v_mov_b32 v33, v49
    v_mov_b32 v34, v50
    v_mov_b32 v35, v51
    v_mov_b32 v36, v52
    v_mov_b32 v37, v53
    v_mov_b32 v38, v54
    v_mov_b32 v39, v55
    v_mov_b32 v40, v56
    v_mov_b32 v41, v57
    v_mov_b32 v42, v58
    v_mov_b32 v43, v59
    v_mov_b32 v44, v60
    v_mov_b32 v45, v61
    v_mov_b32 v46, v62
    v_mov_b32 v47, v63
    buffer_load_dwordx4 v[48:51], v6, s[40:43], s10 offen offset:0
    buffer_load_dwordx4 v[52:55], v6, s[40:43], s10 offen offset:64
    buffer_load_dwordx4 v[56:59], v6, s[40:43], s10 offen offset:128
    buffer_load_dwordx4 v[60:63], v6, s[40:43], s10 offen offset:192
    s_cmp_lt_u32 s9, 2560000
    s_cbranch_scc0 K1_LAST
    v_mfma_f32_16x16x32_bf16 v[96:99], v[32:35], v[128:131], 0
    s_nop 7
    v_mul_f32 v80, s63, v104
    v_mul_f32 v82, s64, v120
    v_cvt_pk_bf16_f32 v81, v80, 0
    v_and_b32 v66, 0x7fffffff, v82
    v_add_u32 v66, 0x8000, v66
    v_mfma_f32_16x16x32_bf16 v[100:103], v[32:35], v[132:135], 0
    v_sub_u32 v66, v66, v81
    v_max_i32 v66, 0, v66
    v_and_or_b32 v66, v66, s61, v81
    v_and_or_b32 v66, v82, s62, v66
    v_mul_f32 v84, s63, v108
    v_mfma_f32_16x16x32_bf16 v[112:115], v[32:35], v[192:195], 0
    v_mul_f32 v86, s64, v124
    v_cvt_pk_bf16_f32 v85, v84, 0
    v_and_b32 v67, 0x7fffffff, v86
    v_add_u32 v67, 0x8000, v67
    v_sub_u32 v67, v67, v85
    v_mfma_f32_16x16x32_bf16 v[116:119], v[32:35], v[196:199], 0
    v_max_i32 v67, 0, v67
    v_and_or_b32 v67, v67, s61, v85
    v_and_or_b32 v67, v86, s62, v67
    v_mul_f32 v80, s63, v105
    v_mul_f32 v82, s64, v121
    v_mfma_f32_16x16x32_bf16 v[96:99], v[36:39], v[144:147], v[96:99]
    v_cvt_pk_bf16_f32 v81, v80, 0
    v_and_b32 v70, 0x7fffffff, v82
    v_add_u32 v70, 0x8000, v70
    v_sub_u32 v70, v70, v81
    v_max_i32 v70, 0, v70
    v_mfma_f32_16x16x32_bf16 v[100:103], v[36:39], v[148:151], v[100:103]
    v_and_or_b32 v70, v70, s61, v81
    v_and_or_b32 v70, v82, s62, v70
    v_mul_f32 v84, s63, v109
    v_mul_f32 v86, s64, v125
    v_cvt_pk_bf16_f32 v85, v84, 0
    v_mfma_f32_16x16x32_bf16 v[112:115], v[36:39], v[208:211], v[112:115]
    v_and_b32 v71, 0x7fffffff, v86
    v_add_u32 v71, 0x8000, v71
    v_sub_u32 v71, v71, v85
    v_max_i32 v71, 0, v71
    v_and_or_b32 v71, v71, s61, v85
    v_mfma_f32_16x16x32_bf16 v[116:119], v[36:39], v[212:215], v[116:119]
    v_and_or_b32 v71, v86, s62, v71
    v_mul_f32 v80, s63, v106
    v_mul_f32 v82, s64, v122
    v_cvt_pk_bf16_f32 v81, v80, 0
    v_and_b32 v74, 0x7fffffff, v82
    v_mfma_f32_16x16x32_bf16 v[96:99], v[40:43], v[160:163], v[96:99]
    v_add_u32 v74, 0x8000, v74
    v_sub_u32 v74, v74, v81
    v_max_i32 v74, 0, v74
    v_and_or_b32 v74, v74, s61, v81
    v_and_or_b32 v74, v82, s62, v74
    v_mfma_f32_16x16x32_bf16 v[100:103], v[40:43], v[164:167], v[100:103]
    v_mul_f32 v84, s63, v110
    v_mul_f32 v86, s64, v126
    v_cvt_pk_bf16_f32 v85, v84, 0
    v_and_b32 v75, 0x7fffffff, v86
    v_add_u32 v75, 0x8000, v75
    v_mfma_f32_16x16x32_bf16 v[112:115], v[40:43], v[224:227], v[112:115]
    v_sub_u32 v75, v75, v85
    v_max_i32 v75, 0, v75
    v_and_or_b32 v75, v75, s61, v85
    v_and_or_b32 v75, v86, s62, v75
    v_mul_f32 v80, s63, v107
    v_mfma_f32_16x16x32_bf16 v[116:119], v[40:43], v[228:231], v[116:119]
    v_mul_f32 v82, s64, v123
    v_cvt_pk_bf16_f32 v81, v80, 0
    v_and_b32 v78, 0x7fffffff, v82
    v_add_u32 v78, 0x8000, v78
    v_sub_u32 v78, v78, v81
    v_mfma_f32_16x16x32_bf16 v[96:99], v[44:47], v[176:179], v[96:99]
    v_max_i32 v78, 0, v78
    v_and_or_b32 v78, v78, s61, v81
    v_and_or_b32 v78, v82, s62, v78
    v_mul_f32 v84, s63, v111
    v_mul_f32 v86, s64, v127
    v_mfma_f32_16x16x32_bf16 v[100:103], v[44:47], v[180:183], v[100:103]
    v_cvt_pk_bf16_f32 v85, v84, 0
    v_and_b32 v79, 0x7fffffff, v86
    v_add_u32 v79, 0x8000, v79
    v_sub_u32 v79, v79, v85
    v_max_i32 v79, 0, v79
    v_mfma_f32_16x16x32_bf16 v[112:115], v[44:47], v[240:243], v[112:115]
    v_and_or_b32 v79, v79, s61, v85
    v_and_or_b32 v79, v86, s62, v79
    v_mfma_f32_16x16x32_bf16 v[116:119], v[44:47], v[244:247], v[116:119]
    s_lshl_b32 s12, s8, 1
    buffer_store_dwordx4 v[64:67], v7, s[52:55], s12 offen offset:0 nt
    buffer_store_dwordx4 v[68:71], v7, s[52:55], s12 offen offset:512 nt
    buffer_store_dwordx4 v[72:75], v7, s[52:55], s12 offen offset:1024 nt
    buffer_store_dwordx4 v[76:79], v7, s[52:55], s12 offen offset:1536 nt
    s_mov_b32 s8, s9
    s_mov_b32 s9, s10
    s_mov_b32 s10, 0x40000000
    s_branch K1_TILE
K1_LAST:
    v_mul_f32 v80, s63, v104
    v_mul_f32 v82, s64, v120
    v_cvt_pk_bf16_f32 v81, v80, 0
    v_and_b32 v66, 0x7fffffff, v82
    v_add_u32 v66, 0x8000, v66
    v_sub_u32 v66, v66, v81
    v_max_i32 v66, 0, v66
    v_and_or_b32 v66, v66, s61, v81
    v_and_or_b32 v66, v82, s62, v66
    v_mul_f32 v84, s63, v108
    v_mul_f32 v86, s64, v124
    v_cvt_pk_bf16_f32 v85, v84, 0
    v_and_b32 v67, 0x7fffffff, v86
    v_add_u32 v67, 0x8000, v67
    v_sub_u32 v67, v67, v85
    v_max_i32 v67, 0, v67
    v_and_or_b32 v67, v67, s61, v85
    v_and_or_b32 v67, v86, s62, v67
    v_mul_f32 v80, s63, v105
    v_mul_f32 v82, s64, v121
    v_cvt_pk_bf16_f32 v81, v80, 0
    v_and_b32 v70, 0x7fffffff, v82
    v_add_u32 v70, 0x8000, v70
    v_sub_u32 v70, v70, v81
    v_max_i32 v70, 0, v70
    v_and_or_b32 v70, v70, s61, v81
    v_and_or_b32 v70, v82, s62, v70
    v_mul_f32 v84, s63, v109
    v_mul_f32 v86, s64, v125
    v_cvt_pk_bf16_f32 v85, v84, 0
    v_and_b32 v71, 0x7fffffff, v86
    v_add_u32 v71, 0x8000, v71
    v_sub_u32 v71, v71, v85
    v_max_i32 v71, 0, v71
    v_and_or_b32 v71, v71, s61, v85
    v_and_or_b32 v71, v86, s62, v71
    v_mul_f32 v80, s63, v106
    v_mul_f32 v82, s64, v122
    v_cvt_pk_bf16_f32 v81, v80, 0
    v_and_b32 v74, 0x7fffffff, v82
    v_add_u32 v74, 0x8000, v74
    v_sub_u32 v74, v74, v81
    v_max_i32 v74, 0, v74
    v_and_or_b32 v74, v74, s61, v81
    v_and_or_b32 v74, v82, s62, v74
    v_mul_f32 v84, s63, v110
    v_mul_f32 v86, s64, v126
    v_cvt_pk_bf16_f32 v85, v84, 0
    v_and_b32 v75, 0x7fffffff, v86
    v_add_u32 v75, 0x8000, v75
    v_sub_u32 v75, v75, v85
    v_max_i32 v75, 0, v75
    v_and_or_b32 v75, v75, s61, v85
    v_and_or_b32 v75, v86, s62, v75
    v_mul_f32 v80, s63, v107
    v_mul_f32 v82, s64, v123
    v_cvt_pk_bf16_f32 v81, v80, 0
    v_and_b32 v78, 0x7fffffff, v82
    v_add_u32 v78, 0x8000, v78
    v_sub_u32 v78, v78, v81
    v_max_i32 v78, 0, v78
    v_and_or_b32 v78, v78, s61, v81
    v_and_or_b32 v78, v82, s62, v78
    v_mul_f32 v84, s63, v111
    v_mul_f32 v86, s64, v127
    v_cvt_pk_bf16_f32 v85, v84, 0
    v_and_b32 v79, 0x7fffffff, v86
    v_add_u32 v79, 0x8000, v79
    v_sub_u32 v79, v79, v85
    v_max_i32 v79, 0, v79
    v_and_or_b32 v79, v79, s61, v85
    v_and_or_b32 v79, v86, s62, v79
    s_lshl_b32 s12, s8, 1
    buffer_store_dwordx4 v[64:67], v7, s[52:55], s12 offen offset:0 nt
    buffer_store_dwordx4 v[68:71], v7, s[52:55], s12 offen offset:512 nt
    buffer_store_dwordx4 v[72:75], v7, s[52:55], s12 offen offset:1024 nt
    buffer_store_dwordx4 v[76:79], v7, s[52:55], s12 offen offset:1536 nt
    s_branch K1_END
K1_END:
K1_END2:
    s_endpgm
.p2align 8
.globl k2_kernel
.type k2_kernel,@function
k2_kernel:
    s_cmp_ge_u32 s2, 512
    s_cbranch_scc1 K2_END
    s_load_dwordx16 s[16:31], s[0:1], 0
    s_load_dwordx8 s[32:39], s[0:1], 64
    s_mov_b32 s3, s2
    s_mul_i32 s6, s3, 625
    s_add_u32 s6, s6, 31
    s_lshr_b32 s5, s6, 5
    s_add_u32 s6, s6, 625
    s_lshr_b32 s6, s6, 5
    s_sub_u32 s7, s6, s5
    v_and_b32 v3, 63, v0
    v_lshrrev_b32 v58, 6, v0
    v_and_b32 v59, 31, v0
    v_readfirstlane_b32 s8, v58
    v_lshlrev_b32 v1, 4, v59
    v_lshlrev_b32 v24, 4, v0
    v_lshlrev_b32 v62, 5, v0
    v_lshlrev_b32 v61, 4, v0
    v_mov_b32 v20, 0
    v_mov_b32 v21, 0
    v_mov_b32 v22, 0
    v_mov_b32 v23, 0
    ds_write_b128 v61, v[20:23] offset:512
    s_cmp_ge_u32 s8, 4
    s_cbranch_scc1 K2_Z1
    ds_write_b128 v61, v[20:23] offset:16896
    s_cmp_ge_u32 s8, 2
    s_cbranch_scc1 K2_Z1
    v_lshlrev_b32 v60, 2, v0
    ds_write_b32 v60, v20
K2_Z1:
    s_waitcnt lgkmcnt(0)
    s_lshl_b32 s10, s3, 15
    s_add_u32 s40, s38, 10264576
    s_addc_u32 s41, s39, 0
    s_add_u32 s40, s40, s10
    s_addc_u32 s41, s41, 0
    s_and_b32 s41, s41, 0xffff
    s_mov_b32 s42, 32768
    s_mov_b32 s43, 0x20000
    buffer_load_dwordx4 v[34:37], v24, s[40:43], 0 offen
    s_barrier
    s_mov_b32 s68, s28
    s_and_b32 s69, s29, 0xffff
    s_mov_b32 s70, 256
    s_mov_b32 s71, 0x20000
    v_lshrrev_b32 v60, 1, v1
    buffer_load_dwordx2 v[4:5], v60, s[68:71], 0 offen
    s_cmp_ge_u32 s8, 5
    s_cbranch_scc1 K2_NOAU0
    s_lshl_b32 s9, s5, 9
    s_lshl_b32 s12, s7, 9
    s_add_u32 s48, s38, 5144576
    s_addc_u32 s49, s39, 0
    s_add_u32 s48, s48, s9
    s_addc_u32 s49, s49, 0
    s_and_b32 s49, s49, 0xffff
    s_mov_b32 s50, s12
    s_mov_b32 s51, 0x20000
    buffer_load_dwordx4 v[50:53], v62, s[48:51], 0 offen
    buffer_load_dwordx4 v[54:57], v62, s[48:51], 0 offen offset:16
K2_NOAU0:
    s_mov_b32 s44, s16
    s_mov_b32 s45, s17
    s_mov_b32 s46, s34
    s_mov_b32 s47, s35
    s_mov_b32 s64, s38
    s_and_b32 s65, s39, 0xffff
    s_mov_b32 s66, 5120512
    s_mov_b32 s67, 0x20000
    s_mov_b32 s29, 0xbfb8aa3b
    s_mov_b32 s30, 0x40000000
    s_mov_b32 s31, 0
    s_mov_b32 s32, 0
    s_mov_b64 s[24:25], exec
    v_lshrrev_b32 v60, 5, v3
    v_lshl_add_u32 v27, v60, 2, v1
    v_and_b32 v59, 7, v0
    v_lshlrev_b32 v59, 1, v59
    v_add_u32 v58, -1, v59
    v_cmp_gt_u32 vcc, 1000, v0
    s_mov_b64 s[26:27], vcc
    s_cmp_ge_u32 s8, 5
    s_cbranch_scc1 K2_W1
    s_waitcnt vmcnt(3)
    s_branch K2_W2
K2_W1:
    s_waitcnt vmcnt(1)
K2_W2:
    v_mov_b32_dpp v32, v34 quad_perm:[0,0,0,0] row_mask:0xf bank_mask:0xf
    s_nop 1
    v_mov_b32_dpp v32, v32 row_shr:4 row_mask:0xf bank_mask:0xa
    s_nop 0
    v_cndmask_b32 v32, 0, v32, s[26:27]
    v_cmp_lt_u32 s[16:17], v58, v32
    v_cmp_lt_u32 s[18:19], v59, v32
    s_mov_b64 s[20:21], 0
    s_mov_b64 s[22:23], 0
    v_cmp_lt_u32 vcc, 15, v32
    s_cbranch_vccz K2_HAVE
    v_mov_b32_dpp v33, v35 quad_perm:[0,0,0,0] row_mask:0xf bank_mask:0xf
    s_nop 1
    v_mov_b32_dpp v33, v33 row_shr:4 row_mask:0xf bank_mask:0xa
    s_mov_b64 exec, vcc
    s_mov_b32 s10, 0x4000
    buffer_load_dwordx4 v[38:41], v24, s[40:43], s10 offen
    s_mov_b64 exec, s[24:25]
    v_add_u32 v58, 15, v59
    v_cmp_lt_u32 s[20:21], v58, v32
    v_add_u32 v58, 16, v59
    v_cmp_lt_u32 s[22:23], v58, v32
    s_waitcnt vmcnt(0)
    s_branch K2_HAVE2
K2_ROUND:
    s_add_u32 s52, s38, 27041792
    s_addc_u32 s53, s39, 0
    s_and_b32 s53, s53, 0xffff
    s_mov_b32 s54, 5120000
    s_mov_b32 s55, 0x20000
    v_lshlrev_b32 v24, 4, v0
    v_and_b32 v24, 0xffffff80, v24
    buffer_load_dwordx2 v[32:33], v24, s[40:43], 0 offen
    s_waitcnt vmcnt(0)
    v_cmp_gt_u32 vcc, 1000, v0
    s_nop 1
    v_cndmask_b32 v32, 0, v32, vcc
    v_lshrrev_b32 v60, 3, v0
    s_movk_i32 s9, 2560
    v_mul_lo_u32 v60, v60, s9
    v_and_b32 v59, 7, v0
    v_add_u32 v59, s32, v59
    v_cmp_lt_u32 s[26:27], 31, v32
    v_add_u32 v58, 0, v59
    v_cmp_lt_u32 s[16:17], v58, v33
    s_and_b64 s[16:17], s[16:17], s[26:27]
    v_add_lshl_u32 v12, v60, v58, 4
    v_add_u32 v58, 8, v59
    v_cmp_lt_u32 s[18:19], v58, v33
    s_and_b64 s[18:19], s[18:19], s[26:27]
    v_add_lshl_u32 v13, v60, v58, 4
    v_add_u32 v58, 16, v59
    v_cmp_lt_u32 s[20:21], v58, v33
    s_and_b64 s[20:21], s[20:21], s[26:27]
    v_add_lshl_u32 v14, v60, v58, 4
    v_add_u32 v58, 24, v59
    v_cmp_lt_u32 s[22:23], v58, v33
    s_and_b64 s[22:23], s[22:23], s[26:27]
    v_add_lshl_u32 v15, v60, v58, 4
    s_mov_b64 exec, s[16:17]
    s_cbranch_execz K2_NOLD0
    buffer_load_dwordx4 v[42:45], v12, s[52:55], 0 offen
K2_NOLD0:
    s_mov_b64 exec, s[18:19]
    s_cbranch_execz K2_NOLD1
    buffer_load_dwordx4 v[46:49], v13, s[52:55], 0 offen
K2_NOLD1:
    s_mov_b64 exec, s[20:21]
    s_cbranch_execz K2_NOLD2
    buffer_load_dwordx4 v[50:53], v14, s[52:55], 0 offen
K2_NOLD2:
    s_mov_b64 exec, s[22:23]
    s_cbranch_execz K2_NOLD3
    buffer_load_dwordx4 v[54:57], v15, s[52:55], 0 offen
K2_NOLD3:
    s_mov_b64 exec, s[24:25]
    s_add_u32 s32, s32, 32
    s_waitcnt vmcnt(0) lgkmcnt(0)
    s_barrier
    v_cmp_eq_u32 vcc, s3, v44
    s_and_b64 s[16:17], s[16:17], vcc
    v_mov_b32 v34, v42
    v_mov_b32 v35, v43
    v_cmp_eq_u32 vcc, s3, v48
    s_and_b64 s[18:19], s[18:19], vcc
    v_mov_b32 v36, v46
    v_mov_b32 v37, v47
    v_cmp_eq_u32 vcc, s3, v52
    s_and_b64 s[20:21], s[20:21], vcc
    v_mov_b32 v38, v50
    v_mov_b32 v39, v51
    v_cmp_eq_u32 vcc, s3, v56
    s_and_b64 s[22:23], s[22:23], vcc
    v_mov_b32 v40, v54
    v_mov_b32 v41, v55
K2_HAVE2:
    v_cmp_lt_u32 vcc, 31, v32
    v_cmp_lt_u32 s[26:27], s32, v33
    s_and_b64 vcc, vcc, s[26:27]
    s_and_saveexec_b64 s[26:27], vcc
    s_cbranch_execz K2_NOFLAG2
    v_mov_b32 v58, 1
    v_mov_b32 v59, 256
    ds_write_b32 v59, v58
K2_NOFLAG2:
    s_mov_b64 exec, s[24:25]
K2_HAVE:
    v_mov_b32 v58, 1
    s_or_b64 s[26:27], s[20:21], s[22:23]
    v_and_b32 v46, 0x7c, v35
    s_mov_b64 exec, s[16:17]
    ds_add_rtn_u32 v42, v46, v58 offset:0
    s_mov_b64 exec, s[24:25]
    v_and_b32 v47, 0x7c, v37
    s_mov_b64 exec, s[18:19]
    ds_add_rtn_u32 v43, v47, v58 offset:0
    s_mov_b64 exec, s[24:25]
    s_cmp_eq_u64 s[26:27], 0
    s_cbranch_scc1 K2_SK1
    v_and_b32 v48, 0x7c, v39
    s_mov_b64 exec, s[20:21]
    ds_add_rtn_u32 v44, v48, v58 offset:0
    s_mov_b64 exec, s[24:25]
    v_and_b32 v49, 0x7c, v41
    s_mov_b64 exec, s[22:23]
    ds_add_rtn_u32 v45, v49, v58 offset:0
    s_mov_b64 exec, s[24:25]
K2_SK1:
    s_waitcnt lgkmcnt(0)
    s_barrier
    v_and_b32 v59, 31, v3
    v_lshlrev_b32 v59, 2, v59
    ds_read_b32 v58, v59 offset:0
    v_mov_b32 v60, 256
    ds_read_b32 v60, v60
    s_waitcnt lgkmcnt(0)
    v_add_u32 v25, 1, v58
    v_lshrrev_b32 v25, 1, v25
    v_mov_b32 v26, v25
    v_readfirstlane_b32 s6, v60
    s_nop 1
    v_add_u32_dpp v26, v26, v26 row_shr:1 row_mask:0xf bank_mask:0xf bound_ctrl:0
    s_nop 1
    v_add_u32_dpp v26, v26, v26 row_shr:2 row_mask:0xf bank_mask:0xf bound_ctrl:0
    s_nop 1
    v_add_u32_dpp v26, v26, v26 row_shr:4 row_mask:0xf bank_mask:0xf bound_ctrl:0
    s_nop 1
    v_add_u32_dpp v26, v26, v26 row_shr:8 row_mask:0xf bank_mask:0xf bound_ctrl:0
    s_nop 1
    v_add_u32_dpp v26, v26, v26 row_bcast:15 row_mask:0xa bank_mask:0xf
    s_nop 1
    v_sub_u32 v59, v26, v25
    v_readlane_b32 s9, v26, 31
    ds_bpermute_b32 v12, v46, v59
    ds_bpermute_b32 v13, v47, v59
    s_cmp_eq_u64 s[26:27], 0
    s_cbranch_scc1 K2_SK2
    ds_bpermute_b32 v14, v48, v59
    ds_bpermute_b32 v15, v49, v59
K2_SK2:
    s_waitcnt lgkmcnt(0)
    v_lshl_add_u32 v12, v12, 1, v42
    v_lshlrev_b32 v12, 3, v12
    s_mov_b64 exec, s[16:17]
    ds_write_b64 v12, v[34:35] offset:31232
    s_mov_b64 exec, s[24:25]
    v_lshl_add_u32 v13, v13, 1, v43
    v_lshlrev_b32 v13, 3, v13
    s_mov_b64 exec, s[18:19]
    ds_write_b64 v13, v[36:37] offset:31232
    s_mov_b64 exec, s[24:25]
    s_cmp_eq_u64 s[26:27], 0
    s_cbranch_scc1 K2_SK3
    v_lshl_add_u32 v14, v14, 1, v44
    v_lshlrev_b32 v14, 3, v14
    s_mov_b64 exec, s[20:21]
    ds_write_b64 v14, v[38:39] offset:31232
    s_mov_b64 exec, s[24:25]
    v_lshl_add_u32 v15, v15, 1, v45
    v_lshlrev_b32 v15, 3, v15
    s_mov_b64 exec, s[22:23]
    ds_write_b64 v15, v[40:41] offset:31232
    s_mov_b64 exec, s[24:25]
K2_SK3:
    s_cmp_lg_u32 s8, 15
    s_cbranch_scc1 K2_NOPAD
    v_lshl_add_u32 v59, v59, 1, v58
    v_and_b32 v60, 1, v58
    v_cmp_eq_u32 vcc, 1, v60
    v_mov_b32 v42, 5120000
    v_mov_b32 v43, 0
    v_lshlrev_b32 v46, 3, v59
    s_and_b32 vcc_hi, vcc_hi, 0
    s_and_saveexec_b64 s[26:27], vcc
    s_cbranch_execz K2_NOPAD2
    ds_write_b64 v46, v[42:43] offset:31232
K2_NOPAD2:
    s_mov_b64 exec, s[24:25]
K2_NOPAD:
    s_cmp_lg_u32 s31, 0
    s_cbranch_scc1 K2_NOAU
    s_cmp_ge_u32 s8, 5
    s_cbranch_scc1 K2_NOAL
    s_lshl_b32 s10, s5, 8
    s_lshl_b32 s12, s7, 8
    s_add_u32 s52, s44, s10
    s_addc_u32 s53, s45, 0
    s_and_b32 s53, s53, 0xffff
    s_mov_b32 s54, s12
    s_mov_b32 s55, 0x20000
    s_waitcnt vmcnt(0)
    ds_write_b128 v62, v[50:53] offset:20992
    ds_write_b128 v62, v[54:57] offset:21008
    v_lshlrev_b32 v61, 4, v0
    buffer_load_dwordx4 v[28:31], v61, s[52:55], 0 offen
    s_branch K2_NOAL2
K2_NOAL:
    s_waitcnt vmcnt(0)
K2_NOAL2:
    v_and_b32 v7, 0xffff0000, v5
    v_lshlrev_b32 v6, 16, v5
    v_and_b32 v5, 0xffff0000, v4
    v_lshlrev_b32 v4, 16, v4
    v_mul_f32 v4, s29, v4
    v_mul_f32 v5, s29, v5
    v_mul_f32 v6, s29, v6
    v_mul_f32 v7, s29, v7
K2_NOAU:
    s_mov_b32 s16, 0x3f80
    s_mov_b32 s18, 1.0
    s_mov_b32 s19, 1.0
    s_waitcnt lgkmcnt(0)
    s_barrier
    s_mul_i32 s10, s9, s8
    s_lshr_b32 s10, s10, 4
    s_add_u32 s11, s8, 1
    s_mul_i32 s11, s9, s11
    s_lshr_b32 s11, s11, 4
    s_sub_u32 s12, s11, s10
    s_mov_b32 s17, -1
    s_cmp_eq_u32 s12, 0
    s_cbranch_scc1 K2_MEND
    v_cmp_ge_u32 vcc, s10, v26
    s_bcnt1_i32_b32 s13, vcc_lo
    v_readlane_b32 s14, v26, s13
    v_readlane_b32 s11, v25, s13
    s_sub_u32 s14, s14, s10
    s_lshl_b32 s20, s13, 10
    s_add_u32 s20, s20, 512
    s_mov_b32 s21, s31
    s_cmp_eq_u32 s14, s11
    s_cbranch_scc1 K2_NOHEAD
    s_mov_b32 s17, s13
    s_lshl_b32 s20, s8, 10
    s_add_u32 s20, s20, 62752
    s_mov_b32 s21, 0
K2_NOHEAD:
    s_min_u32 s14, s14, s12
    s_sub_u32 s15, s12, s14
    s_sub_u32 s14, s14, 1
    s_lshr_b32 s48, s12, 2
    s_lshr_b32 s49, s12, 1
    s_add_u32 s50, s48, s49
    s_setprio 3
    v_lshrrev_b32 v2, 5, v3
    v_lshlrev_b32 v2, 3, v2
    s_lshl_b32 s10, s10, 4
    s_add_u32 s10, s10, 31232
    v_add_u32 v2, s10, v2
    ds_read_b64 v[34:35], v2 offset:0
    ds_read_b64 v[36:37], v2 offset:16
    ds_read_b64 v[38:39], v2 offset:32
    ds_read_b64 v[40:41], v2 offset:48
    s_lshl_b32 s10, s13, 9
    v_add_u32 v24, s10, v1
    ds_read_b128 v[8:11], v24 offset:20992
    v_mov_b32 v12, 0
    v_mov_b32 v16, 0
    v_mov_b32 v13, 0
    v_mov_b32 v17, 0
    v_mov_b32 v14, 0
    v_mov_b32 v18, 0
    v_mov_b32 v15, 0
    v_mov_b32 v19, 0
    v_add_u32 v2, 64, v2
    s_waitcnt lgkmcnt(0)
    s_cmp_gt_u32 s12, 0
    s_cselect_b32 s28, 0, s30
    v_add_u32 v24, v34, v1
    buffer_load_dwordx4 v[42:45], v24, s[64:67], s28 offen
    s_cmp_gt_u32 s12, 1
    s_cselect_b32 s28, 0, s30
    v_add_u32 v24, v36, v1
    buffer_load_dwordx4 v[46:49], v24, s[64:67], s28 offen
    s_cmp_gt_u32 s12, 2
    s_cselect_b32 s28, 0, s30
    v_add_u32 v24, v38, v1
    buffer_load_dwordx4 v[50:53], v24, s[64:67], s28 offen
    s_max_u32 s12, s12, 3
    s_sub_u32 s12, s12, 3
    s_lshl_b32 s12, s12, 0
K2_L0:
    v_pk_fma_f32 v[20:21], v[34:35], v[4:5], v[8:9] op_sel:[1,0,0] op_sel_hi:[1,1,1]
    v_pk_fma_f32 v[22:23], v[34:35], v[6:7], v[10:11] op_sel:[1,0,0] op_sel_hi:[1,1,1]
    s_sub_u32 s12, s12, 1
    s_cselect_b32 s28, s30, s28
    s_waitcnt lgkmcnt(0)
    v_add_u32 v24, v40, v1
    buffer_load_dwordx4 v[54:57], v24, s[64:67], s28 offen
    ds_read_b64 v[34:35], v2 offset:0
    s_waitcnt vmcnt(3)
    v_dot2_f32_bf16 v20, v42, s16, v20
    v_dot2_f32_bf16 v21, v43, s16, v21
    v_dot2_f32_bf16 v22, v44, s16, v22
    v_dot2_f32_bf16 v23, v45, s16, v23
    v_exp_f32 v20, v20
    v_exp_f32 v21, v21
    v_exp_f32 v22, v22
    v_exp_f32 v23, v23
    v_pk_add_f32 v[20:21], v[20:21], s[18:19]
    v_pk_add_f32 v[22:23], v[22:23], s[18:19]
    v_rcp_f32 v20, v20
    v_rcp_f32 v21, v21
    v_rcp_f32 v22, v22
    v_rcp_f32 v23, v23
    s_sub_u32 s14, s14, 1
    v_pk_add_f32 v[16:17], v[16:17], v[20:21]
    v_pk_fma_f32 v[12:13], v[20:21], v[42:43], v[12:13]
    v_pk_add_f32 v[18:19], v[18:19], v[22:23]
    v_pk_fma_f32 v[14:15], v[22:23], v[44:45], v[14:15]
    s_cbranch_scc0 K2_N0
    s_movk_i32 s22, 1
    s_branch K2_FLUSH
K2_N0:
K2_L1:
    v_pk_fma_f32 v[20:21], v[36:37], v[4:5], v[8:9] op_sel:[1,0,0] op_sel_hi:[1,1,1]
    v_pk_fma_f32 v[22:23], v[36:37], v[6:7], v[10:11] op_sel:[1,0,0] op_sel_hi:[1,1,1]
    s_sub_u32 s12, s12, 1
    s_cselect_b32 s28, s30, s28
    s_waitcnt lgkmcnt(0)
    v_add_u32 v24, v34, v1
    buffer_load_dwordx4 v[42:45], v24, s[64:67], s28 offen
    ds_read_b64 v[36:37], v2 offset:16
    s_waitcnt vmcnt(3)
    v_dot2_f32_bf16 v20, v46, s16, v20
    v_dot2_f32_bf16 v21, v47, s16, v21
    v_dot2_f32_bf16 v22, v48, s16, v22
    v_dot2_f32_bf16 v23, v49, s16, v23
    v_exp_f32 v20, v20
    v_exp_f32 v21, v21
    v_exp_f32 v22, v22
    v_exp_f32 v23, v23
    v_pk_add_f32 v[20:21], v[20:21], s[18:19]
    v_pk_add_f32 v[22:23], v[22:23], s[18:19]
    v_rcp_f32 v20, v20
    v_rcp_f32 v21, v21
    v_rcp_f32 v22, v22
    v_rcp_f32 v23, v23
    s_sub_u32 s14, s14, 1
    v_pk_add_f32 v[16:17], v[16:17], v[20:21]
    v_pk_fma_f32 v[12:13], v[20:21], v[46:47], v[12:13]
    v_pk_add_f32 v[18:19], v[18:19], v[22:23]
    v_pk_fma_f32 v[14:15], v[22:23], v[48:49], v[14:15]
    s_cbranch_scc0 K2_N1
    s_movk_i32 s22, 2
    s_branch K2_FLUSH
K2_N1:
K2_L2:
    v_pk_fma_f32 v[20:21], v[38:39], v[4:5], v[8:9] op_sel:[1,0,0] op_sel_hi:[1,1,1]
    v_pk_fma_f32 v[22:23], v[38:39], v[6:7], v[10:11] op_sel:[1,0,0] op_sel_hi:[1,1,1]
    s_sub_u32 s12, s12, 1
    s_cselect_b32 s28, s30, s28
    s_waitcnt lgkmcnt(0)
    v_add_u32 v24, v36, v1
    buffer_load_dwordx4 v[46:49], v24, s[64:67], s28 offen
    ds_read_b64 v[38:39], v2 offset:32
    s_waitcnt vmcnt(3)
    v_dot2_f32_bf16 v20, v50, s16, v20
    v_dot2_f32_bf16 v21, v51, s16, v21
    v_dot2_f32_bf16 v22, v52, s16, v22
    v_dot2_f32_bf16 v23, v53, s16, v23
    v_exp_f32 v20, v20
    v_exp_f32 v21, v21
    v_exp_f32 v22, v22
    v_exp_f32 v23, v23
    v_pk_add_f32 v[20:21], v[20:21], s[18:19]
    v_pk_add_f32 v[22:23], v[22:23], s[18:19]
    v_rcp_f32 v20, v20
    v_rcp_f32 v21, v21
    v_rcp_f32 v22, v22
    v_rcp_f32 v23, v23
    s_sub_u32 s14, s14, 1
    v_pk_add_f32 v[16:17], v[16:17], v[20:21]
    v_pk_fma_f32 v[12:13], v[20:21], v[50:51], v[12:13]
    v_pk_add_f32 v[18:19], v[18:19], v[22:23]
    v_pk_fma_f32 v[14:15], v[22:23], v[52:53], v[14:15]
    s_cbranch_scc0 K2_N2
    s_movk_i32 s22, 3
    s_branch K2_FLUSH
K2_N2:
K2_L3:
    v_pk_fma_f32 v[20:21], v[40:41], v[4:5], v[8:9] op_sel:[1,0,0] op_sel_hi:[1,1,1]
    v_pk_fma_f32 v[22:23], v[40:41], v[6:7], v[10:11] op_sel:[1,0,0] op_sel_hi:[1,1,1]
    s_sub_u32 s12, s12, 1
    s_cselect_b32 s28, s30, s28
    s_waitcnt lgkmcnt(0)
    v_add_u32 v24, v38, v1
    buffer_load_dwordx4 v[50:53], v24, s[64:67], s28 offen
    ds_read_b64 v[40:41], v2 offset:48
    s_waitcnt vmcnt(3)
    v_dot2_f32_bf16 v20, v54, s16, v20
    v_dot2_f32_bf16 v21, v55, s16, v21
    v_dot2_f32_bf16 v22, v56, s16, v22
    v_dot2_f32_bf16 v23, v57, s16, v23
    v_exp_f32 v20, v20
    v_exp_f32 v21, v21
    v_exp_f32 v22, v22
    v_exp_f32 v23, v23
    v_pk_add_f32 v[20:21], v[20:21], s[18:19]
    v_pk_add_f32 v[22:23], v[22:23], s[18:19]
    v_rcp_f32 v20, v20
    v_rcp_f32 v21, v21
    v_rcp_f32 v22, v22
    v_rcp_f32 v23, v23
    v_add_u32 v2, 64, v2
    s_sub_u32 s14, s14, 1
    v_pk_add_f32 v[16:17], v[16:17], v[20:21]
    v_pk_fma_f32 v[12:13], v[20:21], v[54:55], v[12:13]
    v_pk_add_f32 v[18:19], v[18:19], v[22:23]
    v_pk_fma_f32 v[14:15], v[22:23], v[56:57], v[14:15]
    s_cbranch_scc0 K2_N3
    s_movk_i32 s22, 0
    s_branch K2_FLUSH
K2_N3:
    s_branch K2_L0
K2_FLUSH:
    s_nop 0
    v_permlane32_swap_b32 v12, v13
    v_permlane32_swap_b32 v14, v15
    v_permlane32_swap_b32 v16, v17
    v_permlane32_swap_b32 v18, v19
    v_add_u32 v24, s20, v27
    s_nop 0
    v_add_f32 v12, v12, v13
    v_add_f32 v14, v14, v15
    v_add_f32 v16, v16, v17
    v_add_f32 v18, v18, v19
    s_cmp_eq_u32 s21, 0
    s_cbranch_scc1 K2_FW
    ds_read_b32 v13, v24
    ds_read_b32 v15, v24 offset:8
    ds_read_b32 v17, v24 offset:512
    ds_read_b32 v19, v24 offset:520
    s_waitcnt lgkmcnt(0)
    v_add_f32 v12, v12, v13
    v_add_f32 v14, v14, v15
    v_add_f32 v16, v16, v17
    v_add_f32 v18, v18, v19
K2_FW:
    ds_write2_b32 v24, v12, v14 offset0:0 offset1:2
    ds_write2_b32 v24, v16, v18 offset0:128 offset1:130
K2_FSK:
    s_cmp_eq_u32 s15, 0
    s_cbranch_scc1 K2_MEND
K2_FN:
    s_add_u32 s13, s13, 1
    v_readlane_b32 s14, v25, s13
    s_cmp_eq_u32 s14, 0
    s_cbranch_scc1 K2_FN
    s_cmp_gt_u32 s15, s50
    s_cbranch_scc1 K2_PD
    s_setprio 2
    s_cmp_gt_u32 s15, s49
    s_cbranch_scc1 K2_PD
    s_setprio 1
    s_cmp_gt_u32 s15, s48
    s_cbranch_scc1 K2_PD
    s_setprio 0
K2_PD:
    s_min_u32 s14, s14, s15
    s_sub_u32 s15, s15, s14
    s_sub_u32 s14, s14, 1
    s_lshl_b32 s10, s13, 9
    v_add_u32 v24, s10, v1
    ds_read_b128 v[8:11], v24 offset:20992
    s_lshl_b32 s20, s13, 10
    s_add_u32 s20, s20, 512
    s_mov_b32 s21, s31
    v_mov_b32 v12, 0
    v_mov_b32 v16, 0
    v_mov_b32 v13, 0
    v_mov_b32 v17, 0
    v_mov_b32 v14, 0
    v_mov_b32 v18, 0
    v_mov_b32 v15, 0
    v_mov_b32 v19, 0
    s_waitcnt lgkmcnt(0)
    s_cmp_eq_u32 s22, 0
    s_cbranch_scc1 K2_L0
    s_cmp_eq_u32 s22, 1
    s_cbranch_scc1 K2_L1
    s_cmp_eq_u32 s22, 2
    s_cbranch_scc1 K2_L2
    s_branch K2_L3
K2_MEND:
    s_setprio 0
    s_waitcnt vmcnt(0) lgkmcnt(0)
    s_lshl_b32 s10, s8, 2
    s_add_u32 s10, s10, 320
    v_mov_b32 v58, s10
    v_mov_b32 v59, s17
    ds_write_b32 v58, v59
    s_waitcnt lgkmcnt(0)
    s_barrier
    s_cmp_ge_u32 s8, 5
    s_cbranch_scc1 K2_FSKIP
    v_lshrrev_b32 v58, 4, v0
    v_lshlrev_b32 v59, 5, v0
    v_and_b32 v59, 0x1e0, v59
    v_lshl_add_u32 v60, v58, 10, v59
    ds_read_b128 v[34:37], v60 offset:512
    ds_read_b128 v[42:45], v60 offset:1024
    ds_read_b128 v[38:41], v60 offset:528
    ds_read_b128 v[46:49], v60 offset:1040
    v_and_b32 v61, 15, v3
    v_lshlrev_b32 v61, 2, v61
    ds_read_b32 v61, v61 offset:320
    s_waitcnt lgkmcnt(0)
    v_lshrrev_b32 v24, 2, v61
    v_cmp_eq_u32 vcc, s8, v24
    s_and_b32 s10, vcc_lo, 0xffff
K2_FOLD:
    s_cmp_eq_u32 s10, 0
    s_cbranch_scc1 K2_FOLDED
    s_ff1_i32_b32 s11, s10
    s_bitset0_b32 s10, s11
    v_readlane_b32 s12, v61, s11
    s_lshl_b32 s13, s11, 10
    s_add_u32 s13, s13, 62752
    v_add_u32 v24, s13, v59
    ds_read_b128 v[50:53], v24 offset:0
    ds_read_b128 v[12:15], v24 offset:512
    ds_read_b128 v[54:57], v24 offset:16
    ds_read_b128 v[16:19], v24 offset:528
    s_and_b32 s12, s12, 3
    s_lshl_b32 s12, s12, 4
    s_mov_b64 s[14:15], 0xffff
    s_lshl_b64 s[14:15], s[14:15], s12
    s_waitcnt lgkmcnt(0)
    s_mov_b64 exec, s[14:15]
    v_add_f32 v34, v34, v50
    v_add_f32 v42, v42, v12
    v_add_f32 v35, v35, v51
    v_add_f32 v43, v43, v13
    v_add_f32 v36, v36, v52
    v_add_f32 v44, v44, v14
    v_add_f32 v37, v37, v53
    v_add_f32 v45, v45, v15
    v_add_f32 v38, v38, v54
    v_add_f32 v46, v46, v16
    v_add_f32 v39, v39, v55
    v_add_f32 v47, v47, v17
    v_add_f32 v40, v40, v56
    v_add_f32 v48, v48, v18
    v_add_f32 v41, v41, v57
    v_add_f32 v49, v49, v19
    s_mov_b64 exec, s[24:25]
    s_branch K2_FOLD
K2_FOLDED:
    s_cmp_eq_u32 s6, 0
    s_cbranch_scc1 K2_FIN
    ds_write_b128 v60, v[34:37] offset:512
    ds_write_b128 v60, v[42:45] offset:1024
    ds_write_b128 v60, v[38:41] offset:528
    ds_write_b128 v60, v[46:49] offset:1040
    s_cmp_ge_u32 s8, 1
    s_cbranch_scc1 K2_NR
    v_lshlrev_b32 v58, 2, v3
    v_mov_b32 v61, 0
    ds_write_b32 v58, v61
    v_mov_b32 v58, 256
    ds_write_b32 v58, v61
    s_branch K2_NR
K2_FSKIP:
    s_cmp_eq_u32 s6, 0
    s_cbranch_scc1 K2_DONE
K2_NR:
    s_mov_b32 s31, 1
    s_branch K2_ROUND
K2_FIN:
    ds_read_b128 v[50:53], v62 offset:20992
    ds_read_b128 v[54:57], v62 offset:21008
    v_lshlrev_b32 v12, 16, v28
    v_and_b32 v13, 0xffff0000, v28
    v_lshlrev_b32 v14, 16, v29
    v_and_b32 v15, 0xffff0000, v29
    v_lshlrev_b32 v16, 16, v30
    v_and_b32 v17, 0xffff0000, v30
    v_lshlrev_b32 v18, 16, v31
    v_and_b32 v19, 0xffff0000, v31
    s_mov_b32 s10, 0x358637bd
    v_add_f32 v42, s10, v42
    v_add_f32 v43, s10, v43
    v_add_f32 v44, s10, v44
    v_add_f32 v45, s10, v45
    v_add_f32 v46, s10, v46
    v_add_f32 v47, s10, v47
    v_add_f32 v48, s10, v48
    v_add_f32 v49, s10, v49
    v_rcp_f32 v42, v42
    v_rcp_f32 v43, v43
    v_rcp_f32 v44, v44
    v_rcp_f32 v45, v45
    v_rcp_f32 v46, v46
    v_rcp_f32 v47, v47
    v_rcp_f32 v48, v48
    v_rcp_f32 v49, v49
    s_waitcnt lgkmcnt(0)
    v_lshlrev_b32 v50, 16, v50
    v_lshlrev_b32 v51, 16, v51
    v_lshlrev_b32 v52, 16, v52
    v_lshlrev_b32 v53, 16, v53
    v_lshlrev_b32 v54, 16, v54
    v_lshlrev_b32 v55, 16, v55
    v_lshlrev_b32 v56, 16, v56
    v_lshlrev_b32 v57, 16, v57
    v_fma_f32 v34, v34, v42, v50
    v_fma_f32 v35, v35, v43, v51
    v_fma_f32 v36, v36, v44, v52
    v_fma_f32 v37, v37, v45, v53
    v_fma_f32 v38, v38, v46, v54
    v_fma_f32 v39, v39, v47, v55
    v_fma_f32 v40, v40, v48, v56
    v_fma_f32 v41, v41, v49, v57
    v_mul_f32 v42, 0, v34
    v_cmp_gt_f32 vcc, v34, 0
    s_nop 1
    v_cndmask_b32 v34, v42, v34, vcc
    v_add_f32 v34, v34, v12
    v_mul_f32 v43, 0, v35
    v_cmp_gt_f32 vcc, v35, 0
    s_nop 1
    v_cndmask_b32 v35, v43, v35, vcc
    v_add_f32 v35, v35, v13
    v_mul_f32 v44, 0, v36
    v_cmp_gt_f32 vcc, v36, 0
    s_nop 1
    v_cndmask_b32 v36, v44, v36, vcc
    v_add_f32 v36, v36, v14
    v_mul_f32 v45, 0, v37
    v_cmp_gt_f32 vcc, v37, 0
    s_nop 1
    v_cndmask_b32 v37, v45, v37, vcc
    v_add_f32 v37, v37, v15
    v_mul_f32 v46, 0, v38
    v_cmp_gt_f32 vcc, v38, 0
    s_nop 1
    v_cndmask_b32 v38, v46, v38, vcc
    v_add_f32 v38, v38, v16
    v_mul_f32 v47, 0, v39
    v_cmp_gt_f32 vcc, v39, 0
    s_nop 1
    v_cndmask_b32 v39, v47, v39, vcc
    v_add_f32 v39, v39, v17
    v_mul_f32 v48, 0, v40
    v_cmp_gt_f32 vcc, v40, 0
    s_nop 1
    v_cndmask_b32 v40, v48, v40, vcc
    v_add_f32 v40, v40, v18
    v_mul_f32 v49, 0, v41
    v_cmp_gt_f32 vcc, v41, 0
    s_nop 1
    v_cndmask_b32 v41, v49, v41, vcc
    v_add_f32 v41, v41, v19
    v_cvt_pk_bf16_f32 v20, v34, v35
    v_cvt_pk_bf16_f32 v21, v36, v37
    v_cvt_pk_bf16_f32 v22, v38, v39
    v_cvt_pk_bf16_f32 v23, v40, v41
    s_lshl_b32 s9, s5, 8
    s_lshl_b32 s12, s7, 8
    s_add_u32 s60, s46, s9
    s_addc_u32 s61, s47, 0
    s_and_b32 s61, s61, 0xffff
    s_mov_b32 s62, s12
    s_mov_b32 s63, 0x20000
    v_lshlrev_b32 v61, 4, v0
    buffer_store_dwordx4 v[20:23], v61, s[60:63], 0 offen
K2_DONE:
K2_END:
    s_endpgm
.section .rodata,"a"
.p2align 6
.amdhsa_kernel k1_kernel
  .amdhsa_next_free_vgpr 256
  .amdhsa_next_free_sgpr 96
  .amdhsa_accum_offset 256
  .amdhsa_group_segment_fixed_size 0
  .amdhsa_kernarg_size 96
  .amdhsa_user_sgpr_count 2
  .amdhsa_user_sgpr_kernarg_segment_ptr 1
  .amdhsa_system_sgpr_workgroup_id_x 1
.end_amdhsa_kernel
.p2align 6
.amdhsa_kernel k2_kernel
  .amdhsa_next_free_vgpr 64
  .amdhsa_next_free_sgpr 72
  .amdhsa_accum_offset 64
  .amdhsa_group_segment_fixed_size 0
  .amdhsa_kernarg_size 96
  .amdhsa_user_sgpr_count 2
  .amdhsa_user_sgpr_kernarg_segment_ptr 1
  .amdhsa_system_sgpr_workgroup_id_x 1
.end_amdhsa_kernel
```
